```python
import torch

def _softmax(x, axis=-1):
    return torch.softmax(x, dim=axis)

def _gelu(x):
    return torch.nn.functional.gelu(x, approximate='tanh')

def _silu(x):
    return torch.nn.functional.silu(x)

def _sigmoid(x):
    return torch.sigmoid(x)

def _layernorm(x, axis=-1, eps=1e-05):
    m = x.mean(dim=axis, keepdim=True)
    v = x.var(dim=axis, keepdim=True, unbiased=False)
    return (x - m) / torch.sqrt(v + eps)

def _scatter_add(tgt, idx, src, axis=0):
    return tgt.clone().index_add_(axis, idx, src)

def _segment_sum(src, seg, n):
    out = torch.zeros((n,) + src.shape[1:], dtype=src.dtype)
    return out.index_add_(0, seg, src)

def _pad(x, pw):
    flat = tuple((v for pair in reversed(pw) for v in pair))
    return torch.nn.functional.pad(x, flat)
kernel_name = 'standalone__tree_speculative_verify_tree_attention_over_candidate_token_tree__decode'

def setup_inputs():

    _w = lambda a: (lambda t: t.to(torch.bfloat16) if t.is_floating_point() else t)(torch.as_tensor(a))
    B, Hq, Hkv, T, C, D = (2, 32, 16, 1, 8192, 128)
    tree_mask = torch.zeros((B, T, T), dtype=float)
    for b in range(B):
        parent = torch.zeros(T, dtype=torch.int64)
        for i in range(1, T):
            parent[i] = int(torch.randint(0, i, (1,)).item())
        for i in range(T):
            j = i
            tree_mask[b, i, j] = 1.0
            while j > 0:
                j = parent[j]
                tree_mask[b, i, j] = 1.0
    return {'q': _w((lambda *s: torch.randn(*s, dtype=torch.bfloat16) * 0.8)(B, Hq, T, D)), 'k_cache': _w((lambda *s: torch.randn(*s, dtype=torch.bfloat16) * 0.8)(B, Hkv, C, D)), 'v_cache': _w((lambda *s: torch.randn(*s, dtype=torch.bfloat16) * 0.05)(B, Hkv, C, D)), 'k_tree': _w((lambda *s: torch.randn(*s, dtype=torch.bfloat16) * 0.8)(B, Hkv, T, D)), 'v_tree': _w((lambda *s: torch.randn(*s, dtype=torch.bfloat16) * 0.05)(B, Hkv, T, D)), 'tree_mask': _w(tree_mask)}

def reference(q, k_cache, v_cache, k_tree, v_tree, tree_mask):
    B, Hq, T, D = q.shape
    Hkv, C = (k_cache.shape[1], k_cache.shape[2])
    rep = Hq // Hkv
    kc = (lambda x, n, axis: torch.repeat_interleave(x, n, dim=axis))(k_cache, rep, axis=1)
    vc = (lambda x, n, axis: torch.repeat_interleave(x, n, dim=axis))(v_cache, rep, axis=1)
    kt = (lambda x, n, axis: torch.repeat_interleave(x, n, dim=axis))(k_tree, rep, axis=1)
    vt = (lambda x, n, axis: torch.repeat_interleave(x, n, dim=axis))(v_tree, rep, axis=1)
    k = torch.concatenate([kc, kt], axis=2)
    v = torch.concatenate([vc, vt], axis=2)
    scale = D ** (-0.5)
    scores = torch.einsum('bhqd,bhkd->bhqk', q, k) * scale
    ctx_mask = torch.ones((B, 1, T, C), dtype=scores.dtype)
    tm = tree_mask[:, None, :, :].clone()
    full_mask = torch.concatenate([ctx_mask, tm], axis=-1)
    scores = scores + (1.0 - full_mask) * -1000000000.0
    p = _softmax(scores, axis=-1)
    return torch.einsum('bhqk,bhkd->bhqd', p, v)
```

```asm
; @launch grid=(256,1,1) block=(576,1,1) lds=90000
.amdgcn_target "amdgcn-amd-amdhsa--gfx950"
.text
.globl standalone__tree_speculative_verify_tree_attention_over_candidate_token_tree__decode_kernel

.p2align 8
.type standalone__tree_speculative_verify_tree_attention_over_candidate_token_tree__decode_kernel,@function
standalone__tree_speculative_verify_tree_attention_over_candidate_token_tree__decode_kernel:
    s_cmp_ge_u32 s2, 256
    s_cbranch_scc1 L_end
    s_memrealtime s[58:59]
    s_load_dwordx16 s[4:19], s[0:1], 0
    s_load_dwordx2 s[20:21], s[0:1], 64
    v_and_b32 v1, 63, v0
    v_lshrrev_b32 v2, 6, v0
    s_and_b32 s23, s2, 7
    s_lshl_b32 s23, s23, 2
    s_bfe_u32 s3, s2, 0x20003
    s_add_u32 s23, s23, s3
    s_lshr_b32 s37, s2, 5
    v_readfirstlane_b32 s22, v2
    v_bfe_u32 v4, v1, 2, 2
    v_lshrrev_b32 v5, 4, v1
    s_lshl_b32 s24, s23, 9
    v_lshlrev_b32 v31, 6, v5
    v_lshl_add_u32 v31, v4, 4, v31
    v_bfe_u32 v3, v1, 1, 1
    v_lshl_add_u32 v31, v3, 8, v31
    v_add_u32 v31, s24, v31
    s_mov_b32 s25, 0x3e0293ee
    s_cmp_eq_u32 s22, 8
    s_cbranch_scc1 L_helper
    s_lshl_b32 s3, s23, 21
    s_add_u32 s3, s3, 4096
    s_mov_b32 s40, 3
    s_bfe_u32 s43, s37, 0x10000
    s_lshl_b32 s43, s43, 14
    s_add_u32 s3, s3, s43
    s_bfe_u32 s43, s37, 0x10001
    s_lshl_b32 s43, s43, 15
    s_add_u32 s3, s3, s43
    s_bfe_u32 s43, s37, 0x10002
    s_lshl_b32 s43, s43, 19
    s_add_u32 s3, s3, s43
    s_bfe_u32 s43, s22, 0x10000
    s_lshl_b32 s43, s43, 13
    s_add_u32 s3, s3, s43
    s_bfe_u32 s43, s22, 0x10001
    s_lshl_b32 s43, s43, 16
    s_add_u32 s3, s3, s43
    s_bfe_u32 s43, s22, 0x10002
    s_lshl_b32 s43, s43, 17
    s_add_u32 s3, s3, s43
    v_and_b32 v7, 15, v1
    v_lshl_add_u32 v7, v7, 4, s3
    v_bfe_u32 v3, v1, 4, 1
    v_lshl_add_u32 v7, v3, 11, v7
    v_bfe_u32 v3, v1, 5, 1
    v_lshl_add_u32 v7, v3, 20, v7
    v_bfe_u32 v3, v1, 2, 1
    v_lshl_add_u32 v6, v3, 11, s3
    v_bfe_u32 v3, v1, 3, 1
    v_lshl_add_u32 v3, v3, 20, v6
    v_lshl_add_u32 v3, v5, 6, v3
    v_and_b32 v6, 3, v1
    v_lshl_add_u32 v6, v6, 4, v3
    s_mov_b32 s46, 0x1000
    s_mov_b32 s47, 0x1000
    s_waitcnt lgkmcnt(0)
    global_load_dwordx4 v[8:11], v31, s[4:5]
    global_load_dwordx4 v[40:43], v6, s[6:7] offset:-4096 nt
    global_load_dwordx4 v[44:47], v6, s[6:7] offset:-3840 nt
    global_load_dwordx4 v[48:51], v6, s[6:7] offset:-3584 nt
    global_load_dwordx4 v[52:55], v6, s[6:7] offset:-3328 nt
    s_mov_b32 s54, s58
    s_mov_b32 s53, s58
    s_mov_b32 s57, 52480
    s_mov_b32 s48, 14382
    s_add_u32 s58, s58, 1205
    v_and_b32 v3, 1, v1
    v_lshlrev_b32 v3, 4, v3
    v_mov_b32 v4, 0xffff
    v_lshlrev_b32 v28, v3, v4
    v_mov_b32 v32, 0
    v_mov_b32 v33, 0
    v_mov_b32 v34, 0
    v_mov_b32 v35, 0
    v_mov_b32 v36, 0
    v_mov_b32 v37, 0
    v_mov_b32 v38, 0
    v_mov_b32 v39, 0
    v_mov_b32 v12, 0
    v_mov_b32 v13, 0
    v_mov_b32 v14, 0
    v_mov_b32 v15, 0
    v_lshlrev_b32 v30, 4, v0
    v_and_b32 v31, 3, v1
    v_lshlrev_b32 v31, 3, v31
    v_lshl_add_u32 v31, v2, 5, v31
    v_mov_b32 v104, 0
    s_waitcnt vmcnt(3)
    global_load_dwordx4 v[56:59], v6, s[6:7] offset:-3072 nt
    s_waitcnt vmcnt(3)
    global_load_dwordx4 v[60:63], v6, s[6:7] offset:-2816 nt
    s_waitcnt vmcnt(3)
    global_load_dwordx4 v[64:67], v6, s[6:7] offset:-2560 nt
    s_waitcnt vmcnt(3)
    global_load_dwordx4 v[68:71], v6, s[6:7] offset:-2304 nt
    v_add_u32 v6, s46, v6
    s_xor_b32 s46, s46, 0x3e000
L_loopk:
    s_waitcnt vmcnt(7)
    v_mfma_f32_16x16x32_bf16 v[16:19], v[40:43], v[8:11], 0
    s_waitcnt lgkmcnt(0)
    s_sub_u32 s56, s58, s53
    s_lshl_b32 s56, s56, 8
    s_sub_u32 s56, s56, s57
    s_cmp_lt_i32 s56, 15360
    s_cselect_b64 vcc, -1, 0
    s_add_u32 s57, s57, s48
    s_cbranch_vccz L_sk1
    s_waitcnt vmcnt(5)
    s_cmp_lt_i32 s56, 10240
    s_cbranch_scc0 L_sk1
    s_waitcnt vmcnt(4)
    s_cmp_lt_i32 s56, 5120
    s_cbranch_scc0 L_sk1
    s_waitcnt vmcnt(3)
    s_cmp_lt_i32 s56, 0
    s_cbranch_scc0 L_sk1
    s_waitcnt vmcnt(2)
    s_cmp_lt_i32 s56, -7680
    s_cbranch_scc0 L_sk1
    s_waitcnt vmcnt(1)
L_sk1:
    global_load_dwordx4 v[40:43], v6, s[6:7] offset:-4096 nt
    v_mov_b32 v72, v74
    v_mov_b32 v73, v75
    v_mov_b32 v74, v76
    v_mov_b32 v75, v77
    v_mov_b32 v76, v78
    v_mov_b32 v77, v79
    s_waitcnt vmcnt(7)
    v_mfma_f32_16x16x32_bf16 v[20:23], v[44:47], v[8:11], 0
    s_cbranch_vccz L_sk2
    s_waitcnt vmcnt(5)
    s_cmp_lt_i32 s56, 10240
    s_cbranch_scc0 L_sk2
    s_waitcnt vmcnt(4)
    s_cmp_lt_i32 s56, 5120
    s_cbranch_scc0 L_sk2
    s_waitcnt vmcnt(3)
    s_cmp_lt_i32 s56, 0
    s_cbranch_scc0 L_sk2
    s_waitcnt vmcnt(2)
    s_cmp_lt_i32 s56, -7680
    s_cbranch_scc0 L_sk2
    s_waitcnt vmcnt(1)
L_sk2:
    global_load_dwordx4 v[44:47], v6, s[6:7] offset:-3840 nt
    s_memrealtime s[58:59]
    s_nop 5
    v_add_f32_dpp v3, v17, v16 row_ror:12 row_mask:0xf bank_mask:0xf
    v_add_f32_dpp v4, v19, v18 row_ror:12 row_mask:0xf bank_mask:0xf
    s_nop 1
    v_add_f32_dpp v78, v4, v3 row_ror:8 row_mask:0xf bank_mask:0x1
    s_waitcnt vmcnt(7)
    v_mfma_f32_16x16x32_bf16 v[16:19], v[48:51], v[8:11], 0
    s_waitcnt lgkmcnt(0)
    s_sub_u32 s56, s58, s53
    s_lshl_b32 s56, s56, 8
    s_sub_u32 s56, s56, s57
    s_cmp_lt_i32 s56, 15360
    s_cselect_b64 vcc, -1, 0
    s_add_u32 s57, s57, s48
    s_cbranch_vccz L_sk3
    s_waitcnt vmcnt(5)
    s_cmp_lt_i32 s56, 10240
    s_cbranch_scc0 L_sk3
    s_waitcnt vmcnt(4)
    s_cmp_lt_i32 s56, 5120
    s_cbranch_scc0 L_sk3
    s_waitcnt vmcnt(3)
    s_cmp_lt_i32 s56, 0
    s_cbranch_scc0 L_sk3
    s_waitcnt vmcnt(2)
    s_cmp_lt_i32 s56, -7680
    s_cbranch_scc0 L_sk3
    s_waitcnt vmcnt(1)
L_sk3:
    global_load_dwordx4 v[48:51], v6, s[6:7] offset:-3584 nt
    s_nop 5
    v_add_f32_dpp v3, v22, v21 row_ror:12 row_mask:0xf bank_mask:0xf
    v_add_f32_dpp v4, v20, v23 row_ror:12 row_mask:0xf bank_mask:0xf
    s_nop 1
    v_add_f32_dpp v78, v4, v3 row_ror:8 row_mask:0xf bank_mask:0x2
    s_waitcnt vmcnt(7)
    v_mfma_f32_16x16x32_bf16 v[20:23], v[52:55], v[8:11], 0
    s_cbranch_vccz L_sk4
    s_waitcnt vmcnt(5)
    s_cmp_lt_i32 s56, 10240
    s_cbranch_scc0 L_sk4
    s_waitcnt vmcnt(4)
    s_cmp_lt_i32 s56, 5120
    s_cbranch_scc0 L_sk4
    s_waitcnt vmcnt(3)
    s_cmp_lt_i32 s56, 0
    s_cbranch_scc0 L_sk4
    s_waitcnt vmcnt(2)
    s_cmp_lt_i32 s56, -7680
    s_cbranch_scc0 L_sk4
    s_waitcnt vmcnt(1)
L_sk4:
    global_load_dwordx4 v[52:55], v6, s[6:7] offset:-3328 nt
    s_memrealtime s[58:59]
    ds_read_b32 v105, v104 offset:8448
    s_nop 5
    v_add_f32_dpp v3, v19, v18 row_ror:12 row_mask:0xf bank_mask:0xf
    v_add_f32_dpp v4, v17, v16 row_ror:12 row_mask:0xf bank_mask:0xf
    s_nop 1
    v_add_f32_dpp v78, v4, v3 row_ror:8 row_mask:0xf bank_mask:0x4
    s_waitcnt vmcnt(7)
    v_mfma_f32_16x16x32_bf16 v[16:19], v[56:59], v[8:11], 0
    s_waitcnt lgkmcnt(0)
    v_readfirstlane_b32 s52, v105
    s_sub_u32 s56, s54, s52
    s_cmp_lt_u32 s56, 600
    s_cselect_b32 s56, s56, 300
    s_mul_i32 s52, s56, 146
    s_lshr_b32 s52, s52, 4
    s_sub_u32 s48, 17119, s52
    s_mul_i32 s52, s40, 4
    s_sub_u32 s52, 14, s52
    s_mul_i32 s57, s52, s48
    s_add_u32 s57, s57, 52480
    s_sub_u32 s56, s58, s53
    s_lshl_b32 s56, s56, 8
    s_sub_u32 s56, s56, s57
    s_cmp_lt_i32 s56, 15360
    s_cselect_b64 vcc, -1, 0
    s_add_u32 s57, s57, s48
    s_cbranch_vccz L_sk5
    s_waitcnt vmcnt(5)
    s_cmp_lt_i32 s56, 10240
    s_cbranch_scc0 L_sk5
    s_waitcnt vmcnt(4)
    s_cmp_lt_i32 s56, 5120
    s_cbranch_scc0 L_sk5
    s_waitcnt vmcnt(3)
    s_cmp_lt_i32 s56, 0
    s_cbranch_scc0 L_sk5
    s_waitcnt vmcnt(2)
    s_cmp_lt_i32 s56, -7680
    s_cbranch_scc0 L_sk5
    s_waitcnt vmcnt(1)
L_sk5:
    global_load_dwordx4 v[56:59], v6, s[6:7] offset:-3072 nt
    s_nop 5
    v_add_f32_dpp v3, v20, v23 row_ror:12 row_mask:0xf bank_mask:0xf
    v_add_f32_dpp v4, v22, v21 row_ror:12 row_mask:0xf bank_mask:0xf
    s_nop 1
    v_add_f32_dpp v78, v4, v3 row_ror:8 row_mask:0xf bank_mask:0x8
    s_waitcnt vmcnt(7)
    v_mfma_f32_16x16x32_bf16 v[20:23], v[60:63], v[8:11], 0
    s_cbranch_vccz L_sk6
    s_waitcnt vmcnt(5)
    s_cmp_lt_i32 s56, 10240
    s_cbranch_scc0 L_sk6
    s_waitcnt vmcnt(4)
    s_cmp_lt_i32 s56, 5120
    s_cbranch_scc0 L_sk6
    s_waitcnt vmcnt(3)
    s_cmp_lt_i32 s56, 0
    s_cbranch_scc0 L_sk6
    s_waitcnt vmcnt(2)
    s_cmp_lt_i32 s56, -7680
    s_cbranch_scc0 L_sk6
    s_waitcnt vmcnt(1)
L_sk6:
    global_load_dwordx4 v[60:63], v6, s[6:7] offset:-2816 nt
    s_memrealtime s[58:59]
    s_nop 5
    v_add_f32_dpp v3, v17, v16 row_ror:12 row_mask:0xf bank_mask:0xf
    v_add_f32_dpp v4, v19, v18 row_ror:12 row_mask:0xf bank_mask:0xf
    s_nop 1
    v_add_f32_dpp v79, v4, v3 row_ror:8 row_mask:0xf bank_mask:0x1
    s_waitcnt vmcnt(7)
    v_mfma_f32_16x16x32_bf16 v[16:19], v[64:67], v[8:11], 0
    s_waitcnt lgkmcnt(0)
    s_sub_u32 s56, s58, s53
    s_lshl_b32 s56, s56, 8
    s_sub_u32 s56, s56, s57
    s_cmp_lt_i32 s56, 15360
    s_cselect_b64 vcc, -1, 0
    s_add_u32 s57, s57, s48
    s_cbranch_vccz L_sk7
    s_waitcnt vmcnt(5)
    s_cmp_lt_i32 s56, 10240
    s_cbranch_scc0 L_sk7
    s_waitcnt vmcnt(4)
    s_cmp_lt_i32 s56, 5120
    s_cbranch_scc0 L_sk7
    s_waitcnt vmcnt(3)
    s_cmp_lt_i32 s56, 0
    s_cbranch_scc0 L_sk7
    s_waitcnt vmcnt(2)
    s_cmp_lt_i32 s56, -7680
    s_cbranch_scc0 L_sk7
    s_waitcnt vmcnt(1)
L_sk7:
    global_load_dwordx4 v[64:67], v6, s[6:7] offset:-2560 nt
    s_nop 5
    v_add_f32_dpp v3, v22, v21 row_ror:12 row_mask:0xf bank_mask:0xf
    v_add_f32_dpp v4, v20, v23 row_ror:12 row_mask:0xf bank_mask:0xf
    s_nop 1
    v_add_f32_dpp v79, v4, v3 row_ror:8 row_mask:0xf bank_mask:0x2
    s_waitcnt vmcnt(7)
    v_mfma_f32_16x16x32_bf16 v[20:23], v[68:71], v[8:11], 0
    s_cbranch_vccz L_sk8
    s_waitcnt vmcnt(5)
    s_cmp_lt_i32 s56, 10240
    s_cbranch_scc0 L_sk8
    s_waitcnt vmcnt(4)
    s_cmp_lt_i32 s56, 5120
    s_cbranch_scc0 L_sk8
    s_waitcnt vmcnt(3)
    s_cmp_lt_i32 s56, 0
    s_cbranch_scc0 L_sk8
    s_waitcnt vmcnt(2)
    s_cmp_lt_i32 s56, -7680
    s_cbranch_scc0 L_sk8
    s_waitcnt vmcnt(1)
L_sk8:
    global_load_dwordx4 v[68:71], v6, s[6:7] offset:-2304 nt
    v_add_u32 v6, s46, v6
    s_xor_b32 s46, s46, 0x3e000
    s_memrealtime s[58:59]
    s_nop 5
    v_add_f32_dpp v3, v19, v18 row_ror:12 row_mask:0xf bank_mask:0xf
    v_add_f32_dpp v4, v17, v16 row_ror:12 row_mask:0xf bank_mask:0xf
    s_nop 1
    v_add_f32_dpp v79, v4, v3 row_ror:8 row_mask:0xf bank_mask:0x4
    v_add_f32_dpp v3, v20, v23 row_ror:12 row_mask:0xf bank_mask:0xf
    v_add_f32_dpp v4, v22, v21 row_ror:12 row_mask:0xf bank_mask:0xf
    s_nop 1
    v_add_f32_dpp v79, v4, v3 row_ror:8 row_mask:0xf bank_mask:0x8
    s_sub_u32 s40, s40, 1
    s_cmp_lg_u32 s40, 0
    s_cbranch_scc1 L_loopk
    s_waitcnt vmcnt(7)
    v_mfma_f32_16x16x32_bf16 v[16:19], v[40:43], v[8:11], 0
    s_waitcnt lgkmcnt(0)
    s_sub_u32 s56, s58, s53
    s_lshl_b32 s56, s56, 8
    s_sub_u32 s56, s56, s57
    s_cmp_lt_i32 s56, 15360
    s_cselect_b64 vcc, -1, 0
    s_add_u32 s57, s57, s48
    s_cbranch_vccz L_sk9
    s_waitcnt vmcnt(5)
    s_cmp_lt_i32 s56, 10240
    s_cbranch_scc0 L_sk9
    s_waitcnt vmcnt(4)
    s_cmp_lt_i32 s56, 5120
    s_cbranch_scc0 L_sk9
    s_waitcnt vmcnt(3)
    s_cmp_lt_i32 s56, 0
    s_cbranch_scc0 L_sk9
    s_waitcnt vmcnt(2)
    s_cmp_lt_i32 s56, -7680
    s_cbranch_scc0 L_sk9
    s_waitcnt vmcnt(1)
L_sk9:
    global_load_dwordx4 v[40:43], v7, s[8:9] offset:-4096 nt
    v_mov_b32 v72, v74
    v_mov_b32 v73, v75
    v_mov_b32 v74, v76
    v_mov_b32 v75, v77
    v_mov_b32 v76, v78
    v_mov_b32 v77, v79
    s_waitcnt vmcnt(7)
    v_mfma_f32_16x16x32_bf16 v[20:23], v[44:47], v[8:11], 0
    s_cbranch_vccz L_sk10
    s_waitcnt vmcnt(5)
    s_cmp_lt_i32 s56, 10240
    s_cbranch_scc0 L_sk10
    s_waitcnt vmcnt(4)
    s_cmp_lt_i32 s56, 5120
    s_cbranch_scc0 L_sk10
    s_waitcnt vmcnt(3)
    s_cmp_lt_i32 s56, 0
    s_cbranch_scc0 L_sk10
    s_waitcnt vmcnt(2)
    s_cmp_lt_i32 s56, -7680
    s_cbranch_scc0 L_sk10
    s_waitcnt vmcnt(1)
L_sk10:
    global_load_dwordx4 v[44:47], v7, s[8:9] offset:-3840 nt
    s_memrealtime s[58:59]
    s_nop 5
    v_add_f32_dpp v3, v17, v16 row_ror:12 row_mask:0xf bank_mask:0xf
    v_add_f32_dpp v4, v19, v18 row_ror:12 row_mask:0xf bank_mask:0xf
    s_nop 1
    v_add_f32_dpp v78, v4, v3 row_ror:8 row_mask:0xf bank_mask:0x1
    s_waitcnt vmcnt(7)
    v_mfma_f32_16x16x32_bf16 v[16:19], v[48:51], v[8:11], 0
    s_waitcnt lgkmcnt(0)
    s_sub_u32 s56, s58, s53
    s_lshl_b32 s56, s56, 8
    s_sub_u32 s56, s56, s57
    s_cmp_lt_i32 s56, 15360
    s_cselect_b64 vcc, -1, 0
    s_add_u32 s57, s57, s48
    s_cbranch_vccz L_sk11
    s_waitcnt vmcnt(5)
    s_cmp_lt_i32 s56, 10240
    s_cbranch_scc0 L_sk11
    s_waitcnt vmcnt(4)
    s_cmp_lt_i32 s56, 5120
    s_cbranch_scc0 L_sk11
    s_waitcnt vmcnt(3)
    s_cmp_lt_i32 s56, 0
    s_cbranch_scc0 L_sk11
    s_waitcnt vmcnt(2)
    s_cmp_lt_i32 s56, -7680
    s_cbranch_scc0 L_sk11
    s_waitcnt vmcnt(1)
L_sk11:
    global_load_dwordx4 v[48:51], v7, s[8:9] offset:-3584 nt
    s_nop 5
    v_add_f32_dpp v3, v22, v21 row_ror:12 row_mask:0xf bank_mask:0xf
    v_add_f32_dpp v4, v20, v23 row_ror:12 row_mask:0xf bank_mask:0xf
    s_nop 1
    v_add_f32_dpp v78, v4, v3 row_ror:8 row_mask:0xf bank_mask:0x2
    s_waitcnt vmcnt(7)
    v_mfma_f32_16x16x32_bf16 v[20:23], v[52:55], v[8:11], 0
    s_cbranch_vccz L_sk12
    s_waitcnt vmcnt(5)
    s_cmp_lt_i32 s56, 10240
    s_cbranch_scc0 L_sk12
    s_waitcnt vmcnt(4)
    s_cmp_lt_i32 s56, 5120
    s_cbranch_scc0 L_sk12
    s_waitcnt vmcnt(3)
    s_cmp_lt_i32 s56, 0
    s_cbranch_scc0 L_sk12
    s_waitcnt vmcnt(2)
    s_cmp_lt_i32 s56, -7680
    s_cbranch_scc0 L_sk12
    s_waitcnt vmcnt(1)
L_sk12:
    global_load_dwordx4 v[52:55], v7, s[8:9] offset:-3328 nt
    s_memrealtime s[58:59]
    s_nop 5
    v_add_f32_dpp v3, v19, v18 row_ror:12 row_mask:0xf bank_mask:0xf
    v_add_f32_dpp v4, v17, v16 row_ror:12 row_mask:0xf bank_mask:0xf
    s_nop 1
    v_add_f32_dpp v78, v4, v3 row_ror:8 row_mask:0xf bank_mask:0x4
    s_waitcnt vmcnt(7)
    v_mfma_f32_16x16x32_bf16 v[16:19], v[56:59], v[8:11], 0
    s_waitcnt lgkmcnt(0)
    s_sub_u32 s56, s58, s53
    s_lshl_b32 s56, s56, 8
    s_sub_u32 s56, s56, s57
    s_cmp_lt_i32 s56, 15360
    s_cselect_b64 vcc, -1, 0
    s_add_u32 s57, s57, s48
    s_cbranch_vccz L_sk13
    s_waitcnt vmcnt(5)
    s_cmp_lt_i32 s56, 10240
    s_cbranch_scc0 L_sk13
    s_waitcnt vmcnt(4)
    s_cmp_lt_i32 s56, 5120
    s_cbranch_scc0 L_sk13
    s_waitcnt vmcnt(3)
    s_cmp_lt_i32 s56, 0
    s_cbranch_scc0 L_sk13
    s_waitcnt vmcnt(2)
    s_cmp_lt_i32 s56, -7680
    s_cbranch_scc0 L_sk13
    s_waitcnt vmcnt(1)
L_sk13:
    global_load_dwordx4 v[56:59], v7, s[8:9] offset:-3072 nt
    s_nop 5
    v_add_f32_dpp v3, v20, v23 row_ror:12 row_mask:0xf bank_mask:0xf
    v_add_f32_dpp v4, v22, v21 row_ror:12 row_mask:0xf bank_mask:0xf
    s_nop 1
    v_add_f32_dpp v78, v4, v3 row_ror:8 row_mask:0xf bank_mask:0x8
    s_waitcnt vmcnt(7)
    v_mfma_f32_16x16x32_bf16 v[20:23], v[60:63], v[8:11], 0
    s_cbranch_vccz L_sk14
    s_waitcnt vmcnt(5)
    s_cmp_lt_i32 s56, 10240
    s_cbranch_scc0 L_sk14
    s_waitcnt vmcnt(4)
    s_cmp_lt_i32 s56, 5120
    s_cbranch_scc0 L_sk14
    s_waitcnt vmcnt(3)
    s_cmp_lt_i32 s56, 0
    s_cbranch_scc0 L_sk14
    s_waitcnt vmcnt(2)
    s_cmp_lt_i32 s56, -7680
    s_cbranch_scc0 L_sk14
    s_waitcnt vmcnt(1)
L_sk14:
    global_load_dwordx4 v[60:63], v7, s[8:9] offset:-2816 nt
    s_memrealtime s[58:59]
    s_nop 5
    v_add_f32_dpp v3, v17, v16 row_ror:12 row_mask:0xf bank_mask:0xf
    v_add_f32_dpp v4, v19, v18 row_ror:12 row_mask:0xf bank_mask:0xf
    s_nop 1
    v_add_f32_dpp v79, v4, v3 row_ror:8 row_mask:0xf bank_mask:0x1
    s_waitcnt vmcnt(7)
    v_mfma_f32_16x16x32_bf16 v[16:19], v[64:67], v[8:11], 0
    s_waitcnt lgkmcnt(0)
    s_sub_u32 s56, s58, s53
    s_lshl_b32 s56, s56, 8
    s_sub_u32 s56, s56, s57
    s_cmp_lt_i32 s56, 15360
    s_cselect_b64 vcc, -1, 0
    s_add_u32 s57, s57, s48
    s_cbranch_vccz L_sk15
    s_waitcnt vmcnt(5)
    s_cmp_lt_i32 s56, 10240
    s_cbranch_scc0 L_sk15
    s_waitcnt vmcnt(4)
    s_cmp_lt_i32 s56, 5120
    s_cbranch_scc0 L_sk15
    s_waitcnt vmcnt(3)
    s_cmp_lt_i32 s56, 0
    s_cbranch_scc0 L_sk15
    s_waitcnt vmcnt(2)
    s_cmp_lt_i32 s56, -7680
    s_cbranch_scc0 L_sk15
    s_waitcnt vmcnt(1)
L_sk15:
    global_load_dwordx4 v[64:67], v7, s[8:9] offset:-2560 nt
    s_nop 5
    v_add_f32_dpp v3, v22, v21 row_ror:12 row_mask:0xf bank_mask:0xf
    v_add_f32_dpp v4, v20, v23 row_ror:12 row_mask:0xf bank_mask:0xf
    s_nop 1
    v_add_f32_dpp v79, v4, v3 row_ror:8 row_mask:0xf bank_mask:0x2
    s_waitcnt vmcnt(7)
    v_mfma_f32_16x16x32_bf16 v[20:23], v[68:71], v[8:11], 0
    s_cbranch_vccz L_sk16
    s_waitcnt vmcnt(5)
    s_cmp_lt_i32 s56, 10240
    s_cbranch_scc0 L_sk16
    s_waitcnt vmcnt(4)
    s_cmp_lt_i32 s56, 5120
    s_cbranch_scc0 L_sk16
    s_waitcnt vmcnt(3)
    s_cmp_lt_i32 s56, 0
    s_cbranch_scc0 L_sk16
    s_waitcnt vmcnt(2)
    s_cmp_lt_i32 s56, -7680
    s_cbranch_scc0 L_sk16
    s_waitcnt vmcnt(1)
L_sk16:
    global_load_dwordx4 v[68:71], v7, s[8:9] offset:-2304 nt
    v_add_u32 v7, s47, v7
    s_xor_b32 s47, s47, 0x3e000
    s_memrealtime s[58:59]
    s_nop 5
    v_add_f32_dpp v3, v19, v18 row_ror:12 row_mask:0xf bank_mask:0xf
    v_add_f32_dpp v4, v17, v16 row_ror:12 row_mask:0xf bank_mask:0xf
    s_nop 1
    v_add_f32_dpp v79, v4, v3 row_ror:8 row_mask:0xf bank_mask:0x4
    v_add_f32_dpp v3, v20, v23 row_ror:12 row_mask:0xf bank_mask:0xf
    v_add_f32_dpp v4, v22, v21 row_ror:12 row_mask:0xf bank_mask:0xf
    s_nop 1
    v_add_f32_dpp v79, v4, v3 row_ror:8 row_mask:0xf bank_mask:0x8
    v_max3_f32 v3, v72, v73, v74
    v_max3_f32 v4, v75, v76, v77
    v_max3_f32 v3, v3, v78, v79
    v_max_f32 v3, v3, v4
    s_nop 1
    v_max_f32_dpp v4, v3, v3 row_ror:4 row_mask:0xf bank_mask:0xf
    s_nop 1
    v_max_f32_dpp v3, v4, v4 row_ror:8 row_mask:0xf bank_mask:0xf
    v_mov_b32 v4, v3
    s_nop 1
    v_permlane16_swap_b32 v3, v4
    v_max_f32 v3, v3, v4
    v_mov_b32 v4, v3
    s_nop 1
    v_permlane32_swap_b32 v3, v4
    v_max_f32 v3, v3, v4
    v_mul_f32 v26, s25, v3
    v_fma_f32 v72, v72, s25, -v26
    v_fma_f32 v73, v73, s25, -v26
    v_fma_f32 v74, v74, s25, -v26
    v_fma_f32 v75, v75, s25, -v26
    v_fma_f32 v76, v76, s25, -v26
    v_fma_f32 v77, v77, s25, -v26
    v_fma_f32 v78, v78, s25, -v26
    v_fma_f32 v79, v79, s25, -v26
    v_exp_f32 v72, v72
    v_exp_f32 v73, v73
    v_exp_f32 v74, v74
    v_exp_f32 v75, v75
    v_exp_f32 v76, v76
    v_exp_f32 v77, v77
    v_exp_f32 v78, v78
    v_exp_f32 v79, v79
    v_cvt_pk_bf16_f32 v72, v72, v72
    v_cvt_pk_bf16_f32 v73, v73, v73
    v_cvt_pk_bf16_f32 v74, v74, v74
    v_cvt_pk_bf16_f32 v75, v75, v75
    v_cvt_pk_bf16_f32 v76, v76, v76
    v_cvt_pk_bf16_f32 v77, v77, v77
    v_cvt_pk_bf16_f32 v78, v78, v78
    v_cvt_pk_bf16_f32 v79, v79, v79
    v_and_b32 v72, v72, v28
    v_and_b32 v73, v73, v28
    v_and_b32 v74, v74, v28
    v_and_b32 v75, v75, v28
    v_and_b32 v76, v76, v28
    v_and_b32 v77, v77, v28
    v_and_b32 v78, v78, v28
    v_and_b32 v79, v79, v28
    v_add_f32 v27, v72, v73
    v_add_f32 v3, v74, v75
    v_add_f32 v27, v27, v76
    v_add_f32 v3, v3, v77
    v_add_f32 v27, v27, v78
    v_add_f32 v3, v3, v79
    v_add_f32 v27, v27, v3
    s_nop 1
    v_add_f32_dpp v4, v27, v27 row_ror:4 row_mask:0xf bank_mask:0xf
    s_nop 1
    v_add_f32_dpp v27, v4, v4 row_ror:8 row_mask:0xf bank_mask:0xf
    v_mov_b32 v4, v27
    s_nop 1
    v_permlane16_swap_b32 v27, v4
    v_add_f32 v27, v27, v4
    v_mov_b32 v4, v27
    s_nop 1
    v_permlane32_swap_b32 v27, v4
    v_add_f32 v27, v27, v4
    ds_write_b64 v31, v[26:27] offset:8192
    s_waitcnt lgkmcnt(0)
    s_barrier
    s_mov_b32 s40, 3
L_loopv:
    v_mov_b32_dpp v32, v72 quad_perm:[0,1,2,3] row_mask:0xf bank_mask:0x1
    v_mov_b32_dpp v33, v72 row_ror:4 row_mask:0xf bank_mask:0x2
    v_mov_b32_dpp v34, v72 row_ror:8 row_mask:0xf bank_mask:0x4
    v_mov_b32_dpp v35, v72 row_ror:12 row_mask:0xf bank_mask:0x8
    s_waitcnt vmcnt(7)
    s_nop 0
    v_mfma_f32_16x16x32_bf16 v[12:15], v[32:35], v[40:43], v[12:15]
    s_waitcnt lgkmcnt(0)
    s_sub_u32 s56, s58, s53
    s_lshl_b32 s56, s56, 8
    s_sub_u32 s56, s56, s57
    s_cmp_lt_i32 s56, 15360
    s_cselect_b64 vcc, -1, 0
    s_add_u32 s57, s57, s48
    s_cbranch_vccz L_sk17
    s_waitcnt vmcnt(5)
    s_cmp_lt_i32 s56, 10240
    s_cbranch_scc0 L_sk17
    s_waitcnt vmcnt(4)
    s_cmp_lt_i32 s56, 5120
    s_cbranch_scc0 L_sk17
    s_waitcnt vmcnt(3)
    s_cmp_lt_i32 s56, 0
    s_cbranch_scc0 L_sk17
    s_waitcnt vmcnt(2)
    s_cmp_lt_i32 s56, -7680
    s_cbranch_scc0 L_sk17
    s_waitcnt vmcnt(1)
L_sk17:
    global_load_dwordx4 v[40:43], v7, s[8:9] offset:-4096 nt
    v_mov_b32_dpp v36, v72 row_ror:12 row_mask:0xf bank_mask:0x1
    v_mov_b32_dpp v37, v72 quad_perm:[0,1,2,3] row_mask:0xf bank_mask:0x2
    v_mov_b32_dpp v38, v72 row_ror:4 row_mask:0xf bank_mask:0x4
    v_mov_b32_dpp v39, v72 row_ror:8 row_mask:0xf bank_mask:0x8
    s_waitcnt vmcnt(7)
    s_nop 0
    v_mfma_f32_16x16x32_bf16 v[12:15], v[36:39], v[44:47], v[12:15]
    s_cbranch_vccz L_sk18
    s_waitcnt vmcnt(5)
    s_cmp_lt_i32 s56, 10240
    s_cbranch_scc0 L_sk18
    s_waitcnt vmcnt(4)
    s_cmp_lt_i32 s56, 5120
    s_cbranch_scc0 L_sk18
    s_waitcnt vmcnt(3)
    s_cmp_lt_i32 s56, 0
    s_cbranch_scc0 L_sk18
    s_waitcnt vmcnt(2)
    s_cmp_lt_i32 s56, -7680
    s_cbranch_scc0 L_sk18
    s_waitcnt vmcnt(1)
L_sk18:
    global_load_dwordx4 v[44:47], v7, s[8:9] offset:-3840 nt
    s_memrealtime s[58:59]
    v_mov_b32_dpp v32, v72 row_ror:8 row_mask:0xf bank_mask:0x1
    v_mov_b32_dpp v33, v72 row_ror:12 row_mask:0xf bank_mask:0x2
    v_mov_b32_dpp v34, v72 quad_perm:[0,1,2,3] row_mask:0xf bank_mask:0x4
    v_mov_b32_dpp v35, v72 row_ror:4 row_mask:0xf bank_mask:0x8
    s_waitcnt vmcnt(7)
    s_nop 0
    v_mfma_f32_16x16x32_bf16 v[12:15], v[32:35], v[48:51], v[12:15]
    s_waitcnt lgkmcnt(0)
    s_sub_u32 s56, s58, s53
    s_lshl_b32 s56, s56, 8
    s_sub_u32 s56, s56, s57
    s_cmp_lt_i32 s56, 15360
    s_cselect_b64 vcc, -1, 0
    s_add_u32 s57, s57, s48
    s_cbranch_vccz L_sk19
    s_waitcnt vmcnt(5)
    s_cmp_lt_i32 s56, 10240
    s_cbranch_scc0 L_sk19
    s_waitcnt vmcnt(4)
    s_cmp_lt_i32 s56, 5120
    s_cbranch_scc0 L_sk19
    s_waitcnt vmcnt(3)
    s_cmp_lt_i32 s56, 0
    s_cbranch_scc0 L_sk19
    s_waitcnt vmcnt(2)
    s_cmp_lt_i32 s56, -7680
    s_cbranch_scc0 L_sk19
    s_waitcnt vmcnt(1)
L_sk19:
    global_load_dwordx4 v[48:51], v7, s[8:9] offset:-3584 nt
    v_mov_b32_dpp v36, v72 row_ror:4 row_mask:0xf bank_mask:0x1
    v_mov_b32_dpp v37, v72 row_ror:8 row_mask:0xf bank_mask:0x2
    v_mov_b32_dpp v38, v72 row_ror:12 row_mask:0xf bank_mask:0x4
    v_mov_b32_dpp v39, v72 quad_perm:[0,1,2,3] row_mask:0xf bank_mask:0x8
    s_waitcnt vmcnt(7)
    s_nop 0
    v_mfma_f32_16x16x32_bf16 v[12:15], v[36:39], v[52:55], v[12:15]
    s_cbranch_vccz L_sk20
    s_waitcnt vmcnt(5)
    s_cmp_lt_i32 s56, 10240
    s_cbranch_scc0 L_sk20
    s_waitcnt vmcnt(4)
    s_cmp_lt_i32 s56, 5120
    s_cbranch_scc0 L_sk20
    s_waitcnt vmcnt(3)
    s_cmp_lt_i32 s56, 0
    s_cbranch_scc0 L_sk20
    s_waitcnt vmcnt(2)
    s_cmp_lt_i32 s56, -7680
    s_cbranch_scc0 L_sk20
    s_waitcnt vmcnt(1)
L_sk20:
    global_load_dwordx4 v[52:55], v7, s[8:9] offset:-3328 nt
    s_memrealtime s[58:59]
    v_mov_b32_dpp v32, v73 quad_perm:[0,1,2,3] row_mask:0xf bank_mask:0x1
    v_mov_b32_dpp v33, v73 row_ror:4 row_mask:0xf bank_mask:0x2
    v_mov_b32_dpp v34, v73 row_ror:8 row_mask:0xf bank_mask:0x4
    v_mov_b32_dpp v35, v73 row_ror:12 row_mask:0xf bank_mask:0x8
    s_waitcnt vmcnt(7)
    s_nop 0
    v_mfma_f32_16x16x32_bf16 v[12:15], v[32:35], v[56:59], v[12:15]
    s_waitcnt lgkmcnt(0)
    s_sub_u32 s56, s58, s53
    s_lshl_b32 s56, s56, 8
    s_sub_u32 s56, s56, s57
    s_cmp_lt_i32 s56, 15360
    s_cselect_b64 vcc, -1, 0
    s_add_u32 s57, s57, s48
    s_cbranch_vccz L_sk21
    s_waitcnt vmcnt(5)
    s_cmp_lt_i32 s56, 10240
    s_cbranch_scc0 L_sk21
    s_waitcnt vmcnt(4)
    s_cmp_lt_i32 s56, 5120
    s_cbranch_scc0 L_sk21
    s_waitcnt vmcnt(3)
    s_cmp_lt_i32 s56, 0
    s_cbranch_scc0 L_sk21
    s_waitcnt vmcnt(2)
    s_cmp_lt_i32 s56, -7680
    s_cbranch_scc0 L_sk21
    s_waitcnt vmcnt(1)
L_sk21:
    global_load_dwordx4 v[56:59], v7, s[8:9] offset:-3072 nt
    v_mov_b32_dpp v36, v73 row_ror:12 row_mask:0xf bank_mask:0x1
    v_mov_b32_dpp v37, v73 quad_perm:[0,1,2,3] row_mask:0xf bank_mask:0x2
    v_mov_b32_dpp v38, v73 row_ror:4 row_mask:0xf bank_mask:0x4
    v_mov_b32_dpp v39, v73 row_ror:8 row_mask:0xf bank_mask:0x8
    s_waitcnt vmcnt(7)
    s_nop 0
    v_mfma_f32_16x16x32_bf16 v[12:15], v[36:39], v[60:63], v[12:15]
    s_cbranch_vccz L_sk22
    s_waitcnt vmcnt(5)
    s_cmp_lt_i32 s56, 10240
    s_cbranch_scc0 L_sk22
    s_waitcnt vmcnt(4)
    s_cmp_lt_i32 s56, 5120
    s_cbranch_scc0 L_sk22
    s_waitcnt vmcnt(3)
    s_cmp_lt_i32 s56, 0
    s_cbranch_scc0 L_sk22
    s_waitcnt vmcnt(2)
    s_cmp_lt_i32 s56, -7680
    s_cbranch_scc0 L_sk22
    s_waitcnt vmcnt(1)
L_sk22:
    global_load_dwordx4 v[60:63], v7, s[8:9] offset:-2816 nt
    s_memrealtime s[58:59]
    v_mov_b32_dpp v32, v73 row_ror:8 row_mask:0xf bank_mask:0x1
    v_mov_b32_dpp v33, v73 row_ror:12 row_mask:0xf bank_mask:0x2
    v_mov_b32_dpp v34, v73 quad_perm:[0,1,2,3] row_mask:0xf bank_mask:0x4
    v_mov_b32_dpp v35, v73 row_ror:4 row_mask:0xf bank_mask:0x8
    s_waitcnt vmcnt(7)
    s_nop 0
    v_mfma_f32_16x16x32_bf16 v[12:15], v[32:35], v[64:67], v[12:15]
    s_waitcnt lgkmcnt(0)
    s_sub_u32 s56, s58, s53
    s_lshl_b32 s56, s56, 8
    s_sub_u32 s56, s56, s57
    s_cmp_lt_i32 s56, 15360
    s_cselect_b64 vcc, -1, 0
    s_add_u32 s57, s57, s48
    s_cbranch_vccz L_sk23
    s_waitcnt vmcnt(5)
    s_cmp_lt_i32 s56, 10240
    s_cbranch_scc0 L_sk23
    s_waitcnt vmcnt(4)
    s_cmp_lt_i32 s56, 5120
    s_cbranch_scc0 L_sk23
    s_waitcnt vmcnt(3)
    s_cmp_lt_i32 s56, 0
    s_cbranch_scc0 L_sk23
    s_waitcnt vmcnt(2)
    s_cmp_lt_i32 s56, -7680
    s_cbranch_scc0 L_sk23
    s_waitcnt vmcnt(1)
L_sk23:
    global_load_dwordx4 v[64:67], v7, s[8:9] offset:-2560 nt
    v_mov_b32_dpp v36, v73 row_ror:4 row_mask:0xf bank_mask:0x1
    v_mov_b32_dpp v37, v73 row_ror:8 row_mask:0xf bank_mask:0x2
    v_mov_b32_dpp v38, v73 row_ror:12 row_mask:0xf bank_mask:0x4
    v_mov_b32_dpp v39, v73 quad_perm:[0,1,2,3] row_mask:0xf bank_mask:0x8
    s_waitcnt vmcnt(7)
    s_nop 0
    v_mfma_f32_16x16x32_bf16 v[12:15], v[36:39], v[68:71], v[12:15]
    s_cbranch_vccz L_sk24
    s_waitcnt vmcnt(5)
    s_cmp_lt_i32 s56, 10240
    s_cbranch_scc0 L_sk24
    s_waitcnt vmcnt(4)
    s_cmp_lt_i32 s56, 5120
    s_cbranch_scc0 L_sk24
    s_waitcnt vmcnt(3)
    s_cmp_lt_i32 s56, 0
    s_cbranch_scc0 L_sk24
    s_waitcnt vmcnt(2)
    s_cmp_lt_i32 s56, -7680
    s_cbranch_scc0 L_sk24
    s_waitcnt vmcnt(1)
L_sk24:
    global_load_dwordx4 v[68:71], v7, s[8:9] offset:-2304 nt
    v_add_u32 v7, s47, v7
    s_xor_b32 s47, s47, 0x3e000
    s_memrealtime s[58:59]
    v_mov_b32 v72, v74
    v_mov_b32 v73, v75
    v_mov_b32 v74, v76
    v_mov_b32 v75, v77
    v_mov_b32 v76, v78
    v_mov_b32 v77, v79
    s_sub_u32 s40, s40, 1
    s_cmp_lg_u32 s40, 0
    s_cbranch_scc1 L_loopv
    s_waitcnt lgkmcnt(0)
    s_barrier
    v_mov_b32_dpp v32, v72 quad_perm:[0,1,2,3] row_mask:0xf bank_mask:0x1
    v_mov_b32_dpp v33, v72 row_ror:4 row_mask:0xf bank_mask:0x2
    v_mov_b32_dpp v34, v72 row_ror:8 row_mask:0xf bank_mask:0x4
    v_mov_b32_dpp v35, v72 row_ror:12 row_mask:0xf bank_mask:0x8
    s_waitcnt vmcnt(7)
    s_nop 0
    v_mfma_f32_16x16x32_bf16 v[12:15], v[32:35], v[40:43], v[12:15]
    v_mov_b32_dpp v36, v72 row_ror:12 row_mask:0xf bank_mask:0x1
    v_mov_b32_dpp v37, v72 quad_perm:[0,1,2,3] row_mask:0xf bank_mask:0x2
    v_mov_b32_dpp v38, v72 row_ror:4 row_mask:0xf bank_mask:0x4
    v_mov_b32_dpp v39, v72 row_ror:8 row_mask:0xf bank_mask:0x8
    s_waitcnt vmcnt(6)
    s_nop 0
    v_mfma_f32_16x16x32_bf16 v[12:15], v[36:39], v[44:47], v[12:15]
    v_mov_b32_dpp v32, v72 row_ror:8 row_mask:0xf bank_mask:0x1
    v_mov_b32_dpp v33, v72 row_ror:12 row_mask:0xf bank_mask:0x2
    v_mov_b32_dpp v34, v72 quad_perm:[0,1,2,3] row_mask:0xf bank_mask:0x4
    v_mov_b32_dpp v35, v72 row_ror:4 row_mask:0xf bank_mask:0x8
    s_waitcnt vmcnt(5)
    s_nop 0
    v_mfma_f32_16x16x32_bf16 v[12:15], v[32:35], v[48:51], v[12:15]
    v_mov_b32_dpp v36, v72 row_ror:4 row_mask:0xf bank_mask:0x1
    v_mov_b32_dpp v37, v72 row_ror:8 row_mask:0xf bank_mask:0x2
    v_mov_b32_dpp v38, v72 row_ror:12 row_mask:0xf bank_mask:0x4
    v_mov_b32_dpp v39, v72 quad_perm:[0,1,2,3] row_mask:0xf bank_mask:0x8
    s_waitcnt vmcnt(4)
    s_nop 0
    v_mfma_f32_16x16x32_bf16 v[12:15], v[36:39], v[52:55], v[12:15]
    v_mov_b32_dpp v32, v73 quad_perm:[0,1,2,3] row_mask:0xf bank_mask:0x1
    v_mov_b32_dpp v33, v73 row_ror:4 row_mask:0xf bank_mask:0x2
    v_mov_b32_dpp v34, v73 row_ror:8 row_mask:0xf bank_mask:0x4
    v_mov_b32_dpp v35, v73 row_ror:12 row_mask:0xf bank_mask:0x8
    s_waitcnt vmcnt(3)
    s_nop 0
    v_mfma_f32_16x16x32_bf16 v[12:15], v[32:35], v[56:59], v[12:15]
    v_mov_b32_dpp v36, v73 row_ror:12 row_mask:0xf bank_mask:0x1
    v_mov_b32_dpp v37, v73 quad_perm:[0,1,2,3] row_mask:0xf bank_mask:0x2
    v_mov_b32_dpp v38, v73 row_ror:4 row_mask:0xf bank_mask:0x4
    v_mov_b32_dpp v39, v73 row_ror:8 row_mask:0xf bank_mask:0x8
    s_waitcnt vmcnt(2)
    s_nop 0
    v_mfma_f32_16x16x32_bf16 v[12:15], v[36:39], v[60:63], v[12:15]
    v_mov_b32_dpp v32, v73 row_ror:8 row_mask:0xf bank_mask:0x1
    v_mov_b32_dpp v33, v73 row_ror:12 row_mask:0xf bank_mask:0x2
    v_mov_b32_dpp v34, v73 quad_perm:[0,1,2,3] row_mask:0xf bank_mask:0x4
    v_mov_b32_dpp v35, v73 row_ror:4 row_mask:0xf bank_mask:0x8
    s_waitcnt vmcnt(1)
    s_nop 0
    v_mfma_f32_16x16x32_bf16 v[12:15], v[32:35], v[64:67], v[12:15]
    v_mov_b32_dpp v36, v73 row_ror:4 row_mask:0xf bank_mask:0x1
    v_mov_b32_dpp v37, v73 row_ror:8 row_mask:0xf bank_mask:0x2
    v_mov_b32_dpp v38, v73 row_ror:12 row_mask:0xf bank_mask:0x4
    v_mov_b32_dpp v39, v73 quad_perm:[0,1,2,3] row_mask:0xf bank_mask:0x8
    s_waitcnt vmcnt(0)
    s_nop 0
    v_mfma_f32_16x16x32_bf16 v[12:15], v[36:39], v[68:71], v[12:15]
    s_nop 7
    ds_write_b128 v30, v[12:15] offset:0
    s_waitcnt lgkmcnt(0)
    s_barrier
    s_endpgm
L_helper:
    s_lshl_b32 s26, s23, 8
    v_and_b32 v3, 3, v1
    v_lshlrev_b32 v4, 6, v5
    v_lshl_add_u32 v4, v3, 4, v4
    v_add_u32 v4, s26, v4
    v_and_b32 v32, 15, v1
    v_lshlrev_b32 v32, 4, v32
    v_lshl_add_u32 v29, v5, 2, v32
    v_add_u32 v5, s26, v29
    v_add_u32 v29, s24, v29
    s_lshl_b32 s32, s23, 14
    s_lshl_b32 s33, s37, 10
    s_add_u32 s33, s33, s32
    v_lshl_add_u32 v7, v1, 4, s33
    v_bfe_u32 v32, v1, 2, 3
    v_xor_b32 v32, s37, v32
    v_lshlrev_b32 v32, 5, v32
    v_lshl_add_u32 v32, v3, 3, v32
    s_add_u32 s33, s32, 8192
    v_add_u32 v28, s33, v32
    s_lshl_b32 s34, s23, 3
    v_mov_b32 v30, s34
    s_and_b32 s35, s2, 0xf8
    s_lshl_b32 s35, s35, 4
    s_add_u32 s35, s35, 0x80000
    v_and_b32 v38, 7, v1
    v_lshl_add_u32 v38, v38, 2, s35
    s_and_b32 s35, s2, 7
    v_mov_b32 v37, 0
    v_mov_b32 v32, -1
    v_mov_b32 v33, -1
    v_mov_b32 v34, -1
    v_mov_b32 v35, -1
    s_waitcnt lgkmcnt(0)
    v_mov_b32 v36, s58
    s_lshl_b64 exec, 1, s35
    global_store_dword v38, v36, s[20:21] sc1
    s_mov_b64 exec, -1
    global_load_dwordx4 v[8:11], v31, s[4:5]
    global_load_dwordx4 v[20:23], v4, s[10:11]
    global_load_dword v25, v5, s[12:13]
    s_load_dword s27, s[14:15], 0
    global_store_dwordx4 v7, v[32:35], s[20:21] sc1
    s_mov_b64 exec, 15
    global_store_dwordx2 v28, v[32:33], s[20:21] sc1
    s_mov_b64 exec, -1
    v_xor_b32 v100, 1024, v7
    v_xor_b32 v101, 2048, v7
    v_xor_b32 v102, 3072, v7
    v_xor_b32 v103, 4096, v7
    v_xor_b32 v104, 5120, v7
    v_xor_b32 v105, 6144, v7
    v_xor_b32 v31, 7168, v7
    s_waitcnt vmcnt(2) lgkmcnt(0)
    v_mfma_f32_16x16x32_bf16 v[16:19], v[20:23], v[8:11], 0
    v_lshlrev_b32 v24, 16, v25
    v_and_b32 v25, 0xffff0000, v25
    s_lshr_b32 s33, s23, 4
    s_lshl_b32 s33, s33, 4
    s_lshr_b32 s27, s27, s33
    s_lshl_b32 s27, s27, 16
    s_nop 3
    v_add_f32_dpp v3, v17, v16 row_ror:12 row_mask:0xf bank_mask:0xf
    v_add_f32_dpp v4, v19, v18 row_ror:12 row_mask:0xf bank_mask:0xf
    s_nop 1
    v_add_f32_dpp v3, v4, v3 row_ror:8 row_mask:0xf bank_mask:0xf
    s_nop 1
    v_mov_b32_dpp v6, v3 quad_perm:[0,1,2,3] row_mask:0xf bank_mask:0x1
    s_nop 1
    v_mov_b32_dpp v6, v3 row_ror:4 row_mask:0xf bank_mask:0x2
    s_nop 1
    v_mov_b32_dpp v6, v3 row_ror:8 row_mask:0xf bank_mask:0x4
    s_nop 1
    v_mov_b32_dpp v6, v3 row_ror:12 row_mask:0xf bank_mask:0x8
    v_sub_f32 v4, 1.0, s27
    v_mul_f32 v4, 0xceabfb8f, v4
    v_fma_f32 v6, v6, s25, v4
    s_getreg_b32 s39, hwreg(HW_REG_XCC_ID, 0, 4)
    s_add_u32 s39, s39, 1
    v_mov_b32 v37, s39
    v_mov_b32 v36, 1
    s_cmp_eq_u32 s37, 7
    s_cbranch_scc0 L_nopub
    s_mov_b64 exec, 1
    global_atomic_swap v30, v37, s[18:19] offset:4 sc1
    s_mov_b64 exec, -1
L_nopub:
    s_waitcnt vmcnt(0)
    s_mov_b64 exec, 1
    global_atomic_add v30, v36, s[18:19] sc1
    s_mov_b64 exec, -1
    v_and_b32 v3, 31, v1
    v_lshlrev_b32 v8, 3, v3
    v_lshlrev_b32 v9, 4, v1
    s_mov_b32 s36, s37
    s_mov_b32 s33, 4
    s_add_u32 s44, s58, 300
L_tm:
    global_load_dword v39, v38, s[20:21] sc1
    s_sub_u32 s33, s33, 1
    s_waitcnt vmcnt(0)
    v_sub_u32 v39, s44, v39
    v_cmp_gt_u32 vcc, 600, v39
    v_mov_b32 v37, 300
    s_cbranch_scc1 L_tmx
    s_cmp_eq_u64 vcc, -1
    s_cbranch_scc0 L_tm
L_tmx:
    v_cndmask_b32 v39, v37, v39, vcc
    v_mov_b32 v37, v39
    s_nop 1
    v_add_u32_dpp v39, v39, v39 row_ror:4 row_mask:0xf bank_mask:0xf
    v_min_u32_dpp v37, v37, v37 row_ror:4 row_mask:0xf bank_mask:0xf
    s_nop 1
    v_add_u32_dpp v39, v39, v39 row_ror:2 row_mask:0xf bank_mask:0xf
    v_min_u32_dpp v37, v37, v37 row_ror:2 row_mask:0xf bank_mask:0xf
    s_nop 1
    v_add_u32_dpp v39, v39, v39 row_ror:1 row_mask:0xf bank_mask:0xf
    v_min_u32_dpp v37, v37, v37 row_ror:1 row_mask:0xf bank_mask:0xf
    v_mul_u32_u24 v39, 1, v39
    v_mad_u32_u24 v39, 24, v37, v39
    v_lshrrev_b32 v39, 5, v39
    v_sub_u32 v39, s58, v39
    v_mov_b32 v37, 0
    s_mov_b64 exec, 1
    ds_write_b32 v37, v39 offset:8448
    s_mov_b64 exec, -1
    s_barrier
    ds_read_b64 v[26:27], v8 offset:8192
    s_waitcnt lgkmcnt(0)
    v_mov_b32 v32, v26
    s_nop 1
    v_max_f32_dpp v4, v32, v32 row_ror:4 row_mask:0xf bank_mask:0xf
    s_nop 1
    v_max_f32_dpp v32, v4, v4 row_ror:8 row_mask:0xf bank_mask:0xf
    v_mov_b32 v4, v32
    s_nop 1
    v_permlane16_swap_b32 v32, v4
    v_max_f32 v32, v32, v4
    v_sub_f32 v3, v26, v32
    v_exp_f32 v3, v3
    s_nop 0
    v_mul_f32 v33, v3, v27
    s_nop 1
    v_add_f32_dpp v4, v33, v33 row_ror:4 row_mask:0xf bank_mask:0xf
    s_nop 1
    v_add_f32_dpp v33, v4, v4 row_ror:8 row_mask:0xf bank_mask:0xf
    v_mov_b32 v4, v33
    s_nop 1
    v_permlane16_swap_b32 v33, v4
    v_add_f32 v33, v33, v4
    s_cmp_eq_u32 s36, 7
    s_cbranch_scc1 L_collect
    v_min_u32 v32, -2, v32
    v_min_u32 v33, -2, v33
    s_mov_b64 exec, 15
    global_store_dwordx2 v28, v[32:33], s[20:21] sc1
    s_mov_b64 exec, -1
    global_load_dword v36, v30, s[18:19] offset:4 sc1
    v_readlane_b32 s64, v3, 0
    v_readlane_b32 s65, v3, 2
    v_readlane_b32 s66, v3, 4
    v_readlane_b32 s67, v3, 6
    v_readlane_b32 s68, v3, 8
    v_readlane_b32 s69, v3, 10
    v_readlane_b32 s70, v3, 12
    v_readlane_b32 s71, v3, 14
    v_readlane_b32 s72, v3, 16
    v_readlane_b32 s73, v3, 18
    v_readlane_b32 s74, v3, 20
    v_readlane_b32 s75, v3, 22
    v_readlane_b32 s76, v3, 24
    v_readlane_b32 s77, v3, 26
    v_readlane_b32 s78, v3, 28
    v_readlane_b32 s79, v3, 30
    s_waitcnt vmcnt(0)
    v_readfirstlane_b32 s35, v36
    s_barrier
    s_barrier
    ds_read_b128 v[40:43], v9 offset:0
    ds_read_b128 v[44:47], v9 offset:1024
    ds_read_b128 v[48:51], v9 offset:2048
    ds_read_b128 v[52:55], v9 offset:3072
    ds_read_b128 v[56:59], v9 offset:4096
    ds_read_b128 v[60:63], v9 offset:5120
    ds_read_b128 v[64:67], v9 offset:6144
    ds_read_b128 v[68:71], v9 offset:7168
    s_waitcnt lgkmcnt(7)
    v_pk_mul_f32 v[12:13], v[40:41], s[64:65] op_sel:[0,0] op_sel_hi:[1,0]
    v_pk_mul_f32 v[14:15], v[42:43], s[64:65] op_sel:[0,1] op_sel_hi:[1,1]
    s_waitcnt lgkmcnt(6)
    v_pk_fma_f32 v[12:13], v[44:45], s[66:67], v[12:13] op_sel:[0,0,0] op_sel_hi:[1,0,1]
    v_pk_fma_f32 v[14:15], v[46:47], s[66:67], v[14:15] op_sel:[0,1,0] op_sel_hi:[1,1,1]
    s_waitcnt lgkmcnt(5)
    v_pk_fma_f32 v[12:13], v[48:49], s[68:69], v[12:13] op_sel:[0,0,0] op_sel_hi:[1,0,1]
    v_pk_fma_f32 v[14:15], v[50:51], s[68:69], v[14:15] op_sel:[0,1,0] op_sel_hi:[1,1,1]
    s_waitcnt lgkmcnt(4)
    v_pk_fma_f32 v[12:13], v[52:53], s[70:71], v[12:13] op_sel:[0,0,0] op_sel_hi:[1,0,1]
    v_pk_fma_f32 v[14:15], v[54:55], s[70:71], v[14:15] op_sel:[0,1,0] op_sel_hi:[1,1,1]
    s_waitcnt lgkmcnt(3)
    v_pk_fma_f32 v[12:13], v[56:57], s[72:73], v[12:13] op_sel:[0,0,0] op_sel_hi:[1,0,1]
    v_pk_fma_f32 v[14:15], v[58:59], s[72:73], v[14:15] op_sel:[0,1,0] op_sel_hi:[1,1,1]
    s_waitcnt lgkmcnt(2)
    v_pk_fma_f32 v[12:13], v[60:61], s[74:75], v[12:13] op_sel:[0,0,0] op_sel_hi:[1,0,1]
    v_pk_fma_f32 v[14:15], v[62:63], s[74:75], v[14:15] op_sel:[0,1,0] op_sel_hi:[1,1,1]
    s_waitcnt lgkmcnt(1)
    v_pk_fma_f32 v[12:13], v[64:65], s[76:77], v[12:13] op_sel:[0,0,0] op_sel_hi:[1,0,1]
    v_pk_fma_f32 v[14:15], v[66:67], s[76:77], v[14:15] op_sel:[0,1,0] op_sel_hi:[1,1,1]
    s_waitcnt lgkmcnt(0)
    v_pk_fma_f32 v[12:13], v[68:69], s[78:79], v[12:13] op_sel:[0,0,0] op_sel_hi:[1,0,1]
    v_pk_fma_f32 v[14:15], v[70:71], s[78:79], v[14:15] op_sel:[0,1,0] op_sel_hi:[1,1,1]
    v_min_u32 v12, -2, v12
    v_min_u32 v13, -2, v13
    v_min_u32 v14, -2, v14
    v_min_u32 v15, -2, v15
    s_cmp_eq_u32 s35, s39
    s_cbranch_scc0 L_far
    global_store_dwordx4 v7, v[12:15], s[20:21]
    s_endpgm
L_far:
    global_store_dwordx4 v7, v[12:15], s[20:21] sc1
    s_endpgm
L_collect:
    s_mov_b32 s38, 0
L_cnt:
    global_load_dword v36, v30, s[18:19] sc1
    s_add_u32 s38, s38, 1
    s_waitcnt vmcnt(0)
    v_readfirstlane_b32 s36, v36
    s_cmp_ge_u32 s36, 8
    s_cbranch_scc1 L_cntok
    s_cmp_lt_u32 s38, 20000
    s_cbranch_scc1 L_cnt
L_cntok:
    v_min_u32 v26, -2, v32
    v_min_u32 v27, -2, v33
    s_mov_b32 s30, 0xfffffff0
    s_mov_b32 s31, 0xfffffff0
    s_mov_b64 exec, s[30:31]
    global_load_dwordx2 v[26:27], v28, s[20:21] sc1
    s_mov_b64 exec, -1
    v_readlane_b32 s64, v3, 0
    v_readlane_b32 s65, v3, 2
    v_readlane_b32 s66, v3, 4
    v_readlane_b32 s67, v3, 6
    v_readlane_b32 s68, v3, 8
    v_readlane_b32 s69, v3, 10
    v_readlane_b32 s70, v3, 12
    v_readlane_b32 s71, v3, 14
    v_readlane_b32 s72, v3, 16
    v_readlane_b32 s73, v3, 18
    v_readlane_b32 s74, v3, 20
    v_readlane_b32 s75, v3, 22
    v_readlane_b32 s76, v3, 24
    v_readlane_b32 s77, v3, 26
    v_readlane_b32 s78, v3, 28
    v_readlane_b32 s79, v3, 30
    s_mov_b32 s38, 0
L_mlpoll:
    s_waitcnt vmcnt(0)
    v_max_u32 v3, v26, v27
    v_cmp_eq_u32 s[30:31], -1, v3
    s_add_u32 s38, s38, 1
    s_cmp_eq_u64 s[30:31], 0
    s_cbranch_scc1 L_mlok
    s_mov_b64 exec, s[30:31]
    global_load_dwordx2 v[26:27], v28, s[20:21] sc1
    s_mov_b64 exec, -1
    s_cmp_lt_u32 s38, 20000
    s_cbranch_scc1 L_mlpoll
    s_waitcnt vmcnt(0)
L_mlok:
    v_mov_b32 v32, v26
    s_nop 1
    v_max_f32_dpp v4, v32, v32 row_ror:4 row_mask:0xf bank_mask:0xf
    s_nop 1
    v_max_f32_dpp v32, v4, v4 row_ror:8 row_mask:0xf bank_mask:0xf
    v_mov_b32 v4, v32
    s_nop 1
    v_permlane16_swap_b32 v32, v4
    v_max_f32 v32, v32, v4
    v_max_f32 v32, v32, v6
    v_sub_f32 v5, v6, v32
    v_sub_f32 v3, v26, v32
    v_exp_f32 v5, v5
    v_exp_f32 v3, v3
    s_nop 0
    v_mul_f32 v33, v3, v27
    s_nop 1
    v_add_f32_dpp v4, v33, v33 row_ror:4 row_mask:0xf bank_mask:0xf
    s_nop 1
    v_add_f32_dpp v33, v4, v4 row_ror:8 row_mask:0xf bank_mask:0xf
    v_mov_b32 v4, v33
    s_nop 1
    v_permlane16_swap_b32 v33, v4
    v_add_f32 v33, v33, v4
    v_add_f32 v33, v33, v5
    v_rcp_f32 v4, v33
    s_nop 1
    v_mul_f32_dpp v3, v4, v3 quad_perm:[1,1,3,3] row_mask:0xf bank_mask:0xf
    v_mul_f32_dpp v5, v4, v5 quad_perm:[1,1,3,3] row_mask:0xf bank_mask:0xf
    v_readlane_b32 s80, v3, 0
    v_readlane_b32 s81, v3, 2
    v_readlane_b32 s82, v3, 4
    v_readlane_b32 s83, v3, 6
    v_readlane_b32 s84, v3, 8
    v_readlane_b32 s85, v3, 10
    v_readlane_b32 s86, v3, 12
    v_readlane_b32 s87, v3, 14
    v_readlane_b32 s88, v3, 16
    v_readlane_b32 s89, v3, 18
    v_readlane_b32 s90, v3, 20
    v_readlane_b32 s91, v3, 22
    v_readlane_b32 s92, v3, 24
    v_readlane_b32 s93, v3, 26
    v_readlane_b32 s94, v3, 28
    v_readlane_b32 s95, v3, 30
    v_readlane_b32 s96, v5, 0
    v_readlane_b32 s97, v5, 2
    s_mov_b64 s[40:41], -1
    s_mov_b64 s[42:43], -1
    s_mov_b64 s[44:45], -1
    s_mov_b64 s[46:47], -1
    s_mov_b64 s[48:49], -1
    s_mov_b64 s[50:51], -1
    s_mov_b64 s[52:53], -1
    v_pk_mul_f32 v[32:33], v[24:25], s[96:97] op_sel:[0,0] op_sel_hi:[1,0]
    v_pk_mul_f32 v[34:35], v[24:25], s[96:97] op_sel:[0,1] op_sel_hi:[1,1]
    s_barrier
    global_load_dwordx4 v[72:75], v100, s[20:21] sc1
    global_load_dwordx4 v[76:79], v101, s[20:21] sc1
    global_load_dwordx4 v[80:83], v102, s[20:21] sc1
    global_load_dwordx4 v[84:87], v103, s[20:21] sc1
    global_load_dwordx4 v[88:91], v104, s[20:21] sc1
    global_load_dwordx4 v[92:95], v105, s[20:21] sc1
    global_load_dwordx4 v[96:99], v31, s[20:21] sc1
    s_barrier
    ds_read_b128 v[40:43], v9 offset:0
    ds_read_b128 v[44:47], v9 offset:1024
    ds_read_b128 v[48:51], v9 offset:2048
    ds_read_b128 v[52:55], v9 offset:3072
    ds_read_b128 v[56:59], v9 offset:4096
    ds_read_b128 v[60:63], v9 offset:5120
    ds_read_b128 v[64:67], v9 offset:6144
    ds_read_b128 v[68:71], v9 offset:7168
    s_waitcnt lgkmcnt(7)
    v_pk_mul_f32 v[12:13], v[40:41], s[64:65] op_sel:[0,0] op_sel_hi:[1,0]
    v_pk_mul_f32 v[14:15], v[42:43], s[64:65] op_sel:[0,1] op_sel_hi:[1,1]
    s_waitcnt lgkmcnt(6)
    v_pk_fma_f32 v[12:13], v[44:45], s[66:67], v[12:13] op_sel:[0,0,0] op_sel_hi:[1,0,1]
    v_pk_fma_f32 v[14:15], v[46:47], s[66:67], v[14:15] op_sel:[0,1,0] op_sel_hi:[1,1,1]
    s_waitcnt lgkmcnt(5)
    v_pk_fma_f32 v[12:13], v[48:49], s[68:69], v[12:13] op_sel:[0,0,0] op_sel_hi:[1,0,1]
    v_pk_fma_f32 v[14:15], v[50:51], s[68:69], v[14:15] op_sel:[0,1,0] op_sel_hi:[1,1,1]
    s_waitcnt lgkmcnt(4)
    v_pk_fma_f32 v[12:13], v[52:53], s[70:71], v[12:13] op_sel:[0,0,0] op_sel_hi:[1,0,1]
    v_pk_fma_f32 v[14:15], v[54:55], s[70:71], v[14:15] op_sel:[0,1,0] op_sel_hi:[1,1,1]
    s_waitcnt lgkmcnt(3)
    v_pk_fma_f32 v[12:13], v[56:57], s[72:73], v[12:13] op_sel:[0,0,0] op_sel_hi:[1,0,1]
    v_pk_fma_f32 v[14:15], v[58:59], s[72:73], v[14:15] op_sel:[0,1,0] op_sel_hi:[1,1,1]
    s_waitcnt lgkmcnt(2)
    v_pk_fma_f32 v[12:13], v[60:61], s[74:75], v[12:13] op_sel:[0,0,0] op_sel_hi:[1,0,1]
    v_pk_fma_f32 v[14:15], v[62:63], s[74:75], v[14:15] op_sel:[0,1,0] op_sel_hi:[1,1,1]
    s_waitcnt lgkmcnt(1)
    v_pk_fma_f32 v[12:13], v[64:65], s[76:77], v[12:13] op_sel:[0,0,0] op_sel_hi:[1,0,1]
    v_pk_fma_f32 v[14:15], v[66:67], s[76:77], v[14:15] op_sel:[0,1,0] op_sel_hi:[1,1,1]
    s_waitcnt lgkmcnt(0)
    v_pk_fma_f32 v[12:13], v[68:69], s[78:79], v[12:13] op_sel:[0,0,0] op_sel_hi:[1,0,1]
    v_pk_fma_f32 v[14:15], v[70:71], s[78:79], v[14:15] op_sel:[0,1,0] op_sel_hi:[1,1,1]
    v_pk_fma_f32 v[12:13], v[12:13], s[80:81], v[32:33] op_sel:[0,0,0] op_sel_hi:[1,0,1]
    v_pk_fma_f32 v[14:15], v[14:15], s[80:81], v[34:35] op_sel:[0,1,0] op_sel_hi:[1,1,1]
    s_lshl_b32 s38, s38, 16
    global_load_dwordx4 v[72:75], v100, s[20:21] sc1
    global_load_dwordx4 v[76:79], v101, s[20:21] sc1
    global_load_dwordx4 v[80:83], v102, s[20:21] sc1
    global_load_dwordx4 v[84:87], v103, s[20:21] sc1
    global_load_dwordx4 v[88:91], v104, s[20:21] sc1
    global_load_dwordx4 v[92:95], v105, s[20:21] sc1
    global_load_dwordx4 v[96:99], v31, s[20:21] sc1
L_opoll:
    global_load_dwordx4 v[72:75], v100, s[20:21] sc1
    global_load_dwordx4 v[76:79], v101, s[20:21] sc1
    global_load_dwordx4 v[80:83], v102, s[20:21] sc1
    global_load_dwordx4 v[84:87], v103, s[20:21] sc1
    global_load_dwordx4 v[88:91], v104, s[20:21] sc1
    global_load_dwordx4 v[92:95], v105, s[20:21] sc1
    global_load_dwordx4 v[96:99], v31, s[20:21] sc1
    s_waitcnt vmcnt(14)
    v_pk_fma_f32 v[36:37], v[72:73], s[82:83], v[12:13] op_sel:[0,0,0] op_sel_hi:[1,0,1]
    v_pk_fma_f32 v[38:39], v[74:75], s[82:83], v[14:15] op_sel:[0,1,0] op_sel_hi:[1,1,1]
    v_pk_fma_f32 v[36:37], v[76:77], s[84:85], v[36:37] op_sel:[0,0,0] op_sel_hi:[1,0,1]
    v_pk_fma_f32 v[38:39], v[78:79], s[84:85], v[38:39] op_sel:[0,1,0] op_sel_hi:[1,1,1]
    v_pk_fma_f32 v[36:37], v[80:81], s[86:87], v[36:37] op_sel:[0,0,0] op_sel_hi:[1,0,1]
    v_pk_fma_f32 v[38:39], v[82:83], s[86:87], v[38:39] op_sel:[0,1,0] op_sel_hi:[1,1,1]
    v_pk_fma_f32 v[36:37], v[84:85], s[88:89], v[36:37] op_sel:[0,0,0] op_sel_hi:[1,0,1]
    v_pk_fma_f32 v[38:39], v[86:87], s[88:89], v[38:39] op_sel:[0,1,0] op_sel_hi:[1,1,1]
    v_pk_fma_f32 v[36:37], v[88:89], s[90:91], v[36:37] op_sel:[0,0,0] op_sel_hi:[1,0,1]
    v_pk_fma_f32 v[38:39], v[90:91], s[90:91], v[38:39] op_sel:[0,1,0] op_sel_hi:[1,1,1]
    v_pk_fma_f32 v[36:37], v[92:93], s[92:93], v[36:37] op_sel:[0,0,0] op_sel_hi:[1,0,1]
    v_pk_fma_f32 v[38:39], v[94:95], s[92:93], v[38:39] op_sel:[0,1,0] op_sel_hi:[1,1,1]
    v_pk_fma_f32 v[36:37], v[96:97], s[94:95], v[36:37] op_sel:[0,0,0] op_sel_hi:[1,0,1]
    v_pk_fma_f32 v[38:39], v[98:99], s[94:95], v[38:39] op_sel:[0,1,0] op_sel_hi:[1,1,1]
    v_pk_add_f32 v[32:33], v[36:37], v[38:39]
    v_cvt_pk_bf16_f32 v16, v36, v37
    v_cmp_u_f32 vcc, v32, v33
    v_cvt_pk_bf16_f32 v17, v38, v39
    s_add_u32 s38, s38, 1
    s_cmp_eq_u64 vcc, 0
    s_cbranch_scc0 L_retry
L_out:
    global_store_dword v29, v16, s[16:17]
    global_store_dword v29, v17, s[16:17] offset:256
L_end:
    s_endpgm
L_retry:
    s_and_b32 s3, s38, 15
    s_cbranch_scc1 L_opoll
    s_mov_b64 s[30:31], 0
    v_max3_u32 v3, v72, v73, v74
    v_max_u32 v3, v3, v75
    v_cmp_eq_u32 s[40:41], -1, v3
    v_max3_u32 v3, v76, v77, v78
    v_max_u32 v3, v3, v79
    v_cmp_eq_u32 s[42:43], -1, v3
    v_max3_u32 v3, v80, v81, v82
    v_max_u32 v3, v3, v83
    v_cmp_eq_u32 s[44:45], -1, v3
    v_max3_u32 v3, v84, v85, v86
    v_max_u32 v3, v3, v87
    v_cmp_eq_u32 s[46:47], -1, v3
    v_max3_u32 v3, v88, v89, v90
    v_max_u32 v3, v3, v91
    v_cmp_eq_u32 s[48:49], -1, v3
    v_max3_u32 v3, v92, v93, v94
    v_max_u32 v3, v3, v95
    v_cmp_eq_u32 s[50:51], -1, v3
    v_max3_u32 v3, v96, v97, v98
    v_max_u32 v3, v3, v99
    v_cmp_eq_u32 s[52:53], -1, v3
    s_and_b32 s3, s38, 0xffff
    s_cmp_ge_u32 s3, 20000
    s_cbranch_scc1 L_out
    s_or_b64 s[30:31], s[30:31], s[40:41]
    s_or_b64 s[30:31], s[30:31], s[42:43]
    s_or_b64 s[30:31], s[30:31], s[44:45]
    s_or_b64 s[30:31], s[30:31], s[46:47]
    s_or_b64 s[30:31], s[30:31], s[48:49]
    s_or_b64 s[30:31], s[30:31], s[50:51]
    s_or_b64 s[30:31], s[30:31], s[52:53]
    s_cbranch_scc1 L_opoll
    v_pk_fma_f32 v[36:37], v[72:73], s[82:83], v[12:13] op_sel:[0,0,0] op_sel_hi:[1,0,1]
    v_pk_fma_f32 v[38:39], v[74:75], s[82:83], v[14:15] op_sel:[0,1,0] op_sel_hi:[1,1,1]
    v_pk_fma_f32 v[36:37], v[76:77], s[84:85], v[36:37] op_sel:[0,0,0] op_sel_hi:[1,0,1]
    v_pk_fma_f32 v[38:39], v[78:79], s[84:85], v[38:39] op_sel:[0,1,0] op_sel_hi:[1,1,1]
    v_pk_fma_f32 v[36:37], v[80:81], s[86:87], v[36:37] op_sel:[0,0,0] op_sel_hi:[1,0,1]
    v_pk_fma_f32 v[38:39], v[82:83], s[86:87], v[38:39] op_sel:[0,1,0] op_sel_hi:[1,1,1]
    v_pk_fma_f32 v[36:37], v[84:85], s[88:89], v[36:37] op_sel:[0,0,0] op_sel_hi:[1,0,1]
    v_pk_fma_f32 v[38:39], v[86:87], s[88:89], v[38:39] op_sel:[0,1,0] op_sel_hi:[1,1,1]
    v_pk_fma_f32 v[36:37], v[88:89], s[90:91], v[36:37] op_sel:[0,0,0] op_sel_hi:[1,0,1]
    v_pk_fma_f32 v[38:39], v[90:91], s[90:91], v[38:39] op_sel:[0,1,0] op_sel_hi:[1,1,1]
    v_pk_fma_f32 v[36:37], v[92:93], s[92:93], v[36:37] op_sel:[0,0,0] op_sel_hi:[1,0,1]
    v_pk_fma_f32 v[38:39], v[94:95], s[92:93], v[38:39] op_sel:[0,1,0] op_sel_hi:[1,1,1]
    v_pk_fma_f32 v[36:37], v[96:97], s[94:95], v[36:37] op_sel:[0,0,0] op_sel_hi:[1,0,1]
    v_pk_fma_f32 v[38:39], v[98:99], s[94:95], v[38:39] op_sel:[0,1,0] op_sel_hi:[1,1,1]
    v_cvt_pk_bf16_f32 v16, v36, v37
    v_cvt_pk_bf16_f32 v17, v38, v39
    s_branch L_out
.section .rodata,"a"
.p2align 6
.amdhsa_kernel standalone__tree_speculative_verify_tree_attention_over_candidate_token_tree__decode_kernel
  .amdhsa_next_free_vgpr 106
  .amdhsa_next_free_sgpr 100
  .amdhsa_accum_offset 108
  .amdhsa_group_segment_fixed_size 0
  .amdhsa_kernarg_size 72
  .amdhsa_user_sgpr_count 2
  .amdhsa_user_sgpr_kernarg_segment_ptr 1
  .amdhsa_system_sgpr_workgroup_id_x 1
.end_amdhsa_kernel
```
